```python
import torch

def _softmax(x, axis=-1):
    return torch.softmax(x, dim=axis)
def _gelu(x):
    return torch.nn.functional.gelu(x, approximate="tanh")
def _silu(x):
    return torch.nn.functional.silu(x)
def _sigmoid(x):
    return torch.sigmoid(x)
def _layernorm(x, axis=-1, eps=1e-5):
    m = x.mean(dim=axis, keepdim=True)
    v = x.var(dim=axis, keepdim=True, unbiased=False)
    return (x - m) / torch.sqrt(v + eps)
def _scatter_add(tgt, idx, src, axis=0):
    return tgt.clone().index_add_(axis, idx, src)
def _segment_sum(src, seg, n):
    out = torch.zeros((n,) + src.shape[1:], dtype=src.dtype)
    return out.index_add_(0, seg, src)
def _pad(x, pw):
    flat = tuple(v for pair in reversed(pw) for v in pair)
    return torch.nn.functional.pad(x, flat)

kernel_name = 'standalone__instancenorm__sampling'

def setup_inputs():

    _w = (lambda a: (lambda t: t.to(torch.bfloat16) if t.is_floating_point() else t)(torch.as_tensor(a)))
    B, C, H, W = 32, 576, 16, 32
    return {
        "x": _w(abs((lambda *s: torch.randn(*s, dtype=torch.bfloat16) * 0.05)(B, C, H, W))),
        "g": _w((lambda *s: torch.randn(*s, dtype=torch.bfloat16) * 0.05)(C) + 1.0),
        "b": _w((lambda *s: torch.randn(*s, dtype=torch.bfloat16) * 0.4)(C)),
    }

def reference(x, g, b):
    mu = x.mean(axis=(-2, -1), keepdims=True)
    var = ((x - mu) ** 2).mean(axis=(-2, -1), keepdims=True)
    xhat = (x - mu) / torch.sqrt(var + 1e-5)
    return xhat * g.reshape(1, -1, 1, 1) + b.reshape(1, -1, 1, 1)
```

```asm
; @launch grid=(512,1,1) block=(576,1,1) lds=0
.amdgcn_target "amdgcn-amd-amdhsa--gfx950"
.text
.globl standalone__instancenorm__sampling_kernel
.p2align 8
.type standalone__instancenorm__sampling_kernel,@function
standalone__instancenorm__sampling_kernel:
    s_load_dwordx8 s[4:11], s[0:1], 0
    s_setprio 3
    s_cmpk_ge_u32 s2, 512
    s_cbranch_scc1 L_done
    s_and_b32 s3, s2, 7
    s_lshr_b32 s12, s2, 3
    s_mulk_i32 s3, 64
    s_add_u32 s3, s3, s12
    s_mul_i32 s12, s3, 36864
    v_and_b32 v2, 15, v0
    v_lshlrev_b32 v1, 6, v0
    v_mul_u32_u24 v2, 48, v2
    v_sub_u32 v2, v1, v2
    v_add_u32 v2, s12, v2
    s_waitcnt lgkmcnt(0)
    global_load_dwordx4 v[4:7], v2, s[4:5] offset:0 nt
    global_load_dwordx4 v[8:11], v2, s[4:5] offset:256 nt
    global_load_dwordx4 v[12:15], v2, s[4:5] offset:512 nt
    global_load_dwordx4 v[16:19], v2, s[4:5] offset:768 nt
    s_setprio 0
    s_and_b32 s13, s3, 15
    v_readfirstlane_b32 s14, v0
    s_mulk_i32 s13, 72
    v_and_b32 v1, 48, v0
    s_lshr_b32 s14, s14, 3
    s_add_u32 s13, s13, s14
    s_load_dwordx2 s[20:21], s[6:7], s13
    s_load_dwordx2 s[22:23], s[8:9], s13
    s_mov_b32 s17, 0x3b000000
    s_mov_b32 s24, 0x3f803f80
    s_movk_i32 s25, 0x3f80
    s_mov_b32 s26, 0x3f800000
    v_mov_b32 v52, 0
    v_mov_b32 v53, 0
    v_mov_b32 v54, 0
    v_mov_b32 v55, 0
    s_waitcnt vmcnt(0) lgkmcnt(0)
    v_dot2c_f32_bf16 v52, s24, v4
    v_dot2c_f32_bf16 v53, s24, v5
    v_dot2c_f32_bf16 v52, s24, v6
    v_dot2c_f32_bf16 v53, s24, v7
    v_dot2c_f32_bf16 v52, s24, v8
    v_dot2c_f32_bf16 v53, s24, v9
    v_dot2c_f32_bf16 v52, s24, v10
    v_dot2c_f32_bf16 v53, s24, v11
    v_dot2c_f32_bf16 v52, s24, v12
    v_dot2c_f32_bf16 v53, s24, v13
    v_dot2c_f32_bf16 v52, s24, v14
    v_dot2c_f32_bf16 v53, s24, v15
    v_dot2c_f32_bf16 v52, s24, v16
    v_dot2c_f32_bf16 v53, s24, v17
    v_dot2c_f32_bf16 v52, s24, v18
    v_dot2c_f32_bf16 v53, s24, v19
    v_lshrrev_b64 v[56:57], v1, s[20:21]
    v_lshrrev_b64 v[58:59], v1, s[22:23]
    v_lshlrev_b32 v56, 16, v56
    v_add_f32 v52, v52, v53
    v_lshlrev_b32 v58, 16, v58
    s_nop 0
    v_add_f32_dpp v52, v52, v52 row_ror:8 row_mask:0xf bank_mask:0xf
    s_nop 1
    v_add_f32_dpp v52, v52, v52 row_ror:4 row_mask:0xf bank_mask:0xf
    s_nop 1
    v_add_f32_dpp v52, v52, v52 row_ror:2 row_mask:0xf bank_mask:0xf
    s_nop 1
    v_add_f32_dpp v52, v52, v52 row_ror:1 row_mask:0xf bank_mask:0xf
    v_mul_f32 v52, s17, v52
    v_cvt_pk_bf16_f32 v52, 0, v52
    v_dot2_f32_bf16 v20, v4, s25, v52 neg_lo:[0,0,1]
    v_dot2_f32_bf16 v21, v4, s26, v52 neg_lo:[0,0,1]
    v_dot2_f32_bf16 v22, v5, s25, v52 neg_lo:[0,0,1]
    v_dot2_f32_bf16 v23, v5, s26, v52 neg_lo:[0,0,1]
    v_dot2_f32_bf16 v24, v6, s25, v52 neg_lo:[0,0,1]
    v_dot2_f32_bf16 v25, v6, s26, v52 neg_lo:[0,0,1]
    v_dot2_f32_bf16 v26, v7, s25, v52 neg_lo:[0,0,1]
    v_dot2_f32_bf16 v27, v7, s26, v52 neg_lo:[0,0,1]
    v_dot2_f32_bf16 v28, v8, s25, v52 neg_lo:[0,0,1]
    v_dot2_f32_bf16 v29, v8, s26, v52 neg_lo:[0,0,1]
    v_dot2_f32_bf16 v30, v9, s25, v52 neg_lo:[0,0,1]
    v_dot2_f32_bf16 v31, v9, s26, v52 neg_lo:[0,0,1]
    v_dot2_f32_bf16 v32, v10, s25, v52 neg_lo:[0,0,1]
    v_dot2_f32_bf16 v33, v10, s26, v52 neg_lo:[0,0,1]
    v_dot2_f32_bf16 v34, v11, s25, v52 neg_lo:[0,0,1]
    v_dot2_f32_bf16 v35, v11, s26, v52 neg_lo:[0,0,1]
    v_dot2_f32_bf16 v36, v12, s25, v52 neg_lo:[0,0,1]
    v_dot2_f32_bf16 v37, v12, s26, v52 neg_lo:[0,0,1]
    v_dot2_f32_bf16 v38, v13, s25, v52 neg_lo:[0,0,1]
    v_dot2_f32_bf16 v39, v13, s26, v52 neg_lo:[0,0,1]
    v_dot2_f32_bf16 v40, v14, s25, v52 neg_lo:[0,0,1]
    v_dot2_f32_bf16 v41, v14, s26, v52 neg_lo:[0,0,1]
    v_dot2_f32_bf16 v42, v15, s25, v52 neg_lo:[0,0,1]
    v_dot2_f32_bf16 v43, v15, s26, v52 neg_lo:[0,0,1]
    v_dot2_f32_bf16 v44, v16, s25, v52 neg_lo:[0,0,1]
    v_dot2_f32_bf16 v45, v16, s26, v52 neg_lo:[0,0,1]
    v_dot2_f32_bf16 v46, v17, s25, v52 neg_lo:[0,0,1]
    v_dot2_f32_bf16 v47, v17, s26, v52 neg_lo:[0,0,1]
    v_dot2_f32_bf16 v48, v18, s25, v52 neg_lo:[0,0,1]
    v_dot2_f32_bf16 v49, v18, s26, v52 neg_lo:[0,0,1]
    v_dot2_f32_bf16 v50, v19, s25, v52 neg_lo:[0,0,1]
    v_dot2_f32_bf16 v51, v19, s26, v52 neg_lo:[0,0,1]
    v_cvt_pk_bf16_f32 v20, 0, v20
    v_cvt_pk_bf16_f32 v21, 0, v21
    v_cvt_pk_bf16_f32 v22, 0, v22
    v_cvt_pk_bf16_f32 v23, 0, v23
    v_cvt_pk_bf16_f32 v24, 0, v24
    v_cvt_pk_bf16_f32 v25, 0, v25
    v_cvt_pk_bf16_f32 v26, 0, v26
    v_cvt_pk_bf16_f32 v27, 0, v27
    v_cvt_pk_bf16_f32 v28, 0, v28
    v_cvt_pk_bf16_f32 v29, 0, v29
    v_cvt_pk_bf16_f32 v30, 0, v30
    v_cvt_pk_bf16_f32 v31, 0, v31
    v_cvt_pk_bf16_f32 v32, 0, v32
    v_cvt_pk_bf16_f32 v33, 0, v33
    v_cvt_pk_bf16_f32 v34, 0, v34
    v_cvt_pk_bf16_f32 v35, 0, v35
    v_cvt_pk_bf16_f32 v36, 0, v36
    v_cvt_pk_bf16_f32 v37, 0, v37
    v_cvt_pk_bf16_f32 v38, 0, v38
    v_cvt_pk_bf16_f32 v39, 0, v39
    v_cvt_pk_bf16_f32 v40, 0, v40
    v_cvt_pk_bf16_f32 v41, 0, v41
    v_cvt_pk_bf16_f32 v42, 0, v42
    v_cvt_pk_bf16_f32 v43, 0, v43
    v_cvt_pk_bf16_f32 v44, 0, v44
    v_cvt_pk_bf16_f32 v45, 0, v45
    v_cvt_pk_bf16_f32 v46, 0, v46
    v_cvt_pk_bf16_f32 v47, 0, v47
    v_cvt_pk_bf16_f32 v48, 0, v48
    v_cvt_pk_bf16_f32 v49, 0, v49
    v_cvt_pk_bf16_f32 v50, 0, v50
    v_cvt_pk_bf16_f32 v51, 0, v51
    v_pk_mul_f32 v[60:61], v[20:21], v[20:21]
    v_pk_mul_f32 v[62:63], v[22:23], v[22:23]
    v_cvt_pk_bf16_f32 v4, v60, v61
    v_pk_mul_f32 v[60:61], v[24:25], v[24:25]
    v_cvt_pk_bf16_f32 v5, v62, v63
    v_pk_mul_f32 v[62:63], v[26:27], v[26:27]
    v_cvt_pk_bf16_f32 v6, v60, v61
    v_pk_mul_f32 v[60:61], v[28:29], v[28:29]
    v_cvt_pk_bf16_f32 v7, v62, v63
    v_pk_mul_f32 v[62:63], v[30:31], v[30:31]
    v_cvt_pk_bf16_f32 v8, v60, v61
    v_pk_mul_f32 v[60:61], v[32:33], v[32:33]
    v_cvt_pk_bf16_f32 v9, v62, v63
    v_pk_mul_f32 v[62:63], v[34:35], v[34:35]
    v_cvt_pk_bf16_f32 v10, v60, v61
    v_pk_mul_f32 v[60:61], v[36:37], v[36:37]
    v_cvt_pk_bf16_f32 v11, v62, v63
    v_pk_mul_f32 v[62:63], v[38:39], v[38:39]
    v_cvt_pk_bf16_f32 v12, v60, v61
    v_pk_mul_f32 v[60:61], v[40:41], v[40:41]
    v_cvt_pk_bf16_f32 v13, v62, v63
    v_pk_mul_f32 v[62:63], v[42:43], v[42:43]
    v_cvt_pk_bf16_f32 v14, v60, v61
    v_pk_mul_f32 v[60:61], v[44:45], v[44:45]
    v_cvt_pk_bf16_f32 v15, v62, v63
    v_pk_mul_f32 v[62:63], v[46:47], v[46:47]
    v_cvt_pk_bf16_f32 v16, v60, v61
    v_pk_mul_f32 v[60:61], v[48:49], v[48:49]
    v_cvt_pk_bf16_f32 v17, v62, v63
    v_pk_mul_f32 v[62:63], v[50:51], v[50:51]
    v_cvt_pk_bf16_f32 v18, v60, v61
    v_cvt_pk_bf16_f32 v19, v62, v63
    v_dot2c_f32_bf16 v54, s24, v4
    v_dot2c_f32_bf16 v55, s24, v5
    v_dot2c_f32_bf16 v54, s24, v6
    v_dot2c_f32_bf16 v55, s24, v7
    v_dot2c_f32_bf16 v54, s24, v8
    v_dot2c_f32_bf16 v55, s24, v9
    v_dot2c_f32_bf16 v54, s24, v10
    v_dot2c_f32_bf16 v55, s24, v11
    v_dot2c_f32_bf16 v54, s24, v12
    v_dot2c_f32_bf16 v55, s24, v13
    v_dot2c_f32_bf16 v54, s24, v14
    v_dot2c_f32_bf16 v55, s24, v15
    v_dot2c_f32_bf16 v54, s24, v16
    v_dot2c_f32_bf16 v55, s24, v17
    v_dot2c_f32_bf16 v54, s24, v18
    v_dot2c_f32_bf16 v55, s24, v19
    s_nop 2
    v_add_f32 v54, v54, v55
    s_nop 1
    v_add_f32_dpp v54, v54, v54 row_ror:8 row_mask:0xf bank_mask:0xf
    s_nop 1
    v_add_f32_dpp v54, v54, v54 row_ror:4 row_mask:0xf bank_mask:0xf
    s_nop 1
    v_add_f32_dpp v54, v54, v54 row_ror:2 row_mask:0xf bank_mask:0xf
    s_nop 1
    v_add_f32_dpp v54, v54, v54 row_ror:1 row_mask:0xf bank_mask:0xf
    v_mul_f32 v54, s17, v54
    v_cvt_pk_bf16_f32 v54, 0, v54
    v_add_f32 v54, 0x37280000, v54
    v_cvt_pk_bf16_f32 v54, 0, v54
    v_sqrt_f32 v54, v54
    s_nop 0
    v_cvt_pk_bf16_f32 v54, 0, v54
    v_rcp_f32 v54, v54
    s_nop 0
    v_pk_mul_f32 v[20:21], v[20:21], v[54:55] op_sel_hi:[1,0]
    v_pk_mul_f32 v[22:23], v[22:23], v[54:55] op_sel_hi:[1,0]
    v_pk_mul_f32 v[24:25], v[24:25], v[54:55] op_sel_hi:[1,0]
    v_pk_mul_f32 v[26:27], v[26:27], v[54:55] op_sel_hi:[1,0]
    v_pk_mul_f32 v[28:29], v[28:29], v[54:55] op_sel_hi:[1,0]
    v_pk_mul_f32 v[30:31], v[30:31], v[54:55] op_sel_hi:[1,0]
    v_pk_mul_f32 v[32:33], v[32:33], v[54:55] op_sel_hi:[1,0]
    v_pk_mul_f32 v[34:35], v[34:35], v[54:55] op_sel_hi:[1,0]
    v_pk_mul_f32 v[36:37], v[36:37], v[54:55] op_sel_hi:[1,0]
    v_pk_mul_f32 v[38:39], v[38:39], v[54:55] op_sel_hi:[1,0]
    v_pk_mul_f32 v[40:41], v[40:41], v[54:55] op_sel_hi:[1,0]
    v_pk_mul_f32 v[42:43], v[42:43], v[54:55] op_sel_hi:[1,0]
    v_pk_mul_f32 v[44:45], v[44:45], v[54:55] op_sel_hi:[1,0]
    v_pk_mul_f32 v[46:47], v[46:47], v[54:55] op_sel_hi:[1,0]
    v_pk_mul_f32 v[48:49], v[48:49], v[54:55] op_sel_hi:[1,0]
    v_pk_mul_f32 v[50:51], v[50:51], v[54:55] op_sel_hi:[1,0]
    v_cvt_pk_bf16_f32 v20, 0, v20
    v_cvt_pk_bf16_f32 v21, 0, v21
    v_cvt_pk_bf16_f32 v22, 0, v22
    v_cvt_pk_bf16_f32 v23, 0, v23
    v_cvt_pk_bf16_f32 v24, 0, v24
    v_cvt_pk_bf16_f32 v25, 0, v25
    v_cvt_pk_bf16_f32 v26, 0, v26
    v_cvt_pk_bf16_f32 v27, 0, v27
    v_cvt_pk_bf16_f32 v28, 0, v28
    v_cvt_pk_bf16_f32 v29, 0, v29
    v_cvt_pk_bf16_f32 v30, 0, v30
    v_cvt_pk_bf16_f32 v31, 0, v31
    v_cvt_pk_bf16_f32 v32, 0, v32
    v_cvt_pk_bf16_f32 v33, 0, v33
    v_cvt_pk_bf16_f32 v34, 0, v34
    v_cvt_pk_bf16_f32 v35, 0, v35
    v_cvt_pk_bf16_f32 v36, 0, v36
    v_cvt_pk_bf16_f32 v37, 0, v37
    v_cvt_pk_bf16_f32 v38, 0, v38
    v_cvt_pk_bf16_f32 v39, 0, v39
    v_cvt_pk_bf16_f32 v40, 0, v40
    v_cvt_pk_bf16_f32 v41, 0, v41
    v_cvt_pk_bf16_f32 v42, 0, v42
    v_cvt_pk_bf16_f32 v43, 0, v43
    v_cvt_pk_bf16_f32 v44, 0, v44
    v_cvt_pk_bf16_f32 v45, 0, v45
    v_cvt_pk_bf16_f32 v46, 0, v46
    v_cvt_pk_bf16_f32 v47, 0, v47
    v_cvt_pk_bf16_f32 v48, 0, v48
    v_cvt_pk_bf16_f32 v49, 0, v49
    v_cvt_pk_bf16_f32 v50, 0, v50
    v_cvt_pk_bf16_f32 v51, 0, v51
    v_pk_mul_f32 v[20:21], v[20:21], v[56:57] op_sel_hi:[1,0]
    v_pk_mul_f32 v[22:23], v[22:23], v[56:57] op_sel_hi:[1,0]
    v_pk_mul_f32 v[24:25], v[24:25], v[56:57] op_sel_hi:[1,0]
    v_pk_mul_f32 v[26:27], v[26:27], v[56:57] op_sel_hi:[1,0]
    v_pk_mul_f32 v[28:29], v[28:29], v[56:57] op_sel_hi:[1,0]
    v_pk_mul_f32 v[30:31], v[30:31], v[56:57] op_sel_hi:[1,0]
    v_pk_mul_f32 v[32:33], v[32:33], v[56:57] op_sel_hi:[1,0]
    v_pk_mul_f32 v[34:35], v[34:35], v[56:57] op_sel_hi:[1,0]
    v_pk_mul_f32 v[36:37], v[36:37], v[56:57] op_sel_hi:[1,0]
    v_pk_mul_f32 v[38:39], v[38:39], v[56:57] op_sel_hi:[1,0]
    v_pk_mul_f32 v[40:41], v[40:41], v[56:57] op_sel_hi:[1,0]
    v_pk_mul_f32 v[42:43], v[42:43], v[56:57] op_sel_hi:[1,0]
    v_pk_mul_f32 v[44:45], v[44:45], v[56:57] op_sel_hi:[1,0]
    v_pk_mul_f32 v[46:47], v[46:47], v[56:57] op_sel_hi:[1,0]
    v_pk_mul_f32 v[48:49], v[48:49], v[56:57] op_sel_hi:[1,0]
    v_pk_mul_f32 v[50:51], v[50:51], v[56:57] op_sel_hi:[1,0]
    v_cvt_pk_bf16_f32 v20, 0, v20
    v_cvt_pk_bf16_f32 v21, 0, v21
    v_cvt_pk_bf16_f32 v22, 0, v22
    v_cvt_pk_bf16_f32 v23, 0, v23
    v_cvt_pk_bf16_f32 v24, 0, v24
    v_cvt_pk_bf16_f32 v25, 0, v25
    v_cvt_pk_bf16_f32 v26, 0, v26
    v_cvt_pk_bf16_f32 v27, 0, v27
    v_cvt_pk_bf16_f32 v28, 0, v28
    v_cvt_pk_bf16_f32 v29, 0, v29
    v_cvt_pk_bf16_f32 v30, 0, v30
    v_cvt_pk_bf16_f32 v31, 0, v31
    v_cvt_pk_bf16_f32 v32, 0, v32
    v_cvt_pk_bf16_f32 v33, 0, v33
    v_cvt_pk_bf16_f32 v34, 0, v34
    v_cvt_pk_bf16_f32 v35, 0, v35
    v_cvt_pk_bf16_f32 v36, 0, v36
    v_cvt_pk_bf16_f32 v37, 0, v37
    v_cvt_pk_bf16_f32 v38, 0, v38
    v_cvt_pk_bf16_f32 v39, 0, v39
    v_cvt_pk_bf16_f32 v40, 0, v40
    v_cvt_pk_bf16_f32 v41, 0, v41
    v_cvt_pk_bf16_f32 v42, 0, v42
    v_cvt_pk_bf16_f32 v43, 0, v43
    v_cvt_pk_bf16_f32 v44, 0, v44
    v_cvt_pk_bf16_f32 v45, 0, v45
    v_cvt_pk_bf16_f32 v46, 0, v46
    v_cvt_pk_bf16_f32 v47, 0, v47
    v_cvt_pk_bf16_f32 v48, 0, v48
    v_cvt_pk_bf16_f32 v49, 0, v49
    v_cvt_pk_bf16_f32 v50, 0, v50
    v_cvt_pk_bf16_f32 v51, 0, v51
    v_pk_add_f32 v[20:21], v[20:21], v[58:59] op_sel_hi:[1,0]
    v_pk_add_f32 v[22:23], v[22:23], v[58:59] op_sel_hi:[1,0]
    v_pk_add_f32 v[24:25], v[24:25], v[58:59] op_sel_hi:[1,0]
    v_pk_add_f32 v[26:27], v[26:27], v[58:59] op_sel_hi:[1,0]
    v_pk_add_f32 v[28:29], v[28:29], v[58:59] op_sel_hi:[1,0]
    v_pk_add_f32 v[30:31], v[30:31], v[58:59] op_sel_hi:[1,0]
    v_pk_add_f32 v[32:33], v[32:33], v[58:59] op_sel_hi:[1,0]
    v_pk_add_f32 v[34:35], v[34:35], v[58:59] op_sel_hi:[1,0]
    v_pk_add_f32 v[36:37], v[36:37], v[58:59] op_sel_hi:[1,0]
    v_pk_add_f32 v[38:39], v[38:39], v[58:59] op_sel_hi:[1,0]
    v_pk_add_f32 v[40:41], v[40:41], v[58:59] op_sel_hi:[1,0]
    v_pk_add_f32 v[42:43], v[42:43], v[58:59] op_sel_hi:[1,0]
    v_pk_add_f32 v[44:45], v[44:45], v[58:59] op_sel_hi:[1,0]
    v_pk_add_f32 v[46:47], v[46:47], v[58:59] op_sel_hi:[1,0]
    v_pk_add_f32 v[48:49], v[48:49], v[58:59] op_sel_hi:[1,0]
    v_pk_add_f32 v[50:51], v[50:51], v[58:59] op_sel_hi:[1,0]
    v_cvt_pk_bf16_f32 v4, v20, v21
    v_cvt_pk_bf16_f32 v5, v22, v23
    v_cvt_pk_bf16_f32 v6, v24, v25
    v_cvt_pk_bf16_f32 v7, v26, v27
    v_cvt_pk_bf16_f32 v8, v28, v29
    v_cvt_pk_bf16_f32 v9, v30, v31
    v_cvt_pk_bf16_f32 v10, v32, v33
    v_cvt_pk_bf16_f32 v11, v34, v35
    v_cvt_pk_bf16_f32 v12, v36, v37
    v_cvt_pk_bf16_f32 v13, v38, v39
    v_cvt_pk_bf16_f32 v14, v40, v41
    v_cvt_pk_bf16_f32 v15, v42, v43
    v_cvt_pk_bf16_f32 v16, v44, v45
    v_cvt_pk_bf16_f32 v17, v46, v47
    v_cvt_pk_bf16_f32 v18, v48, v49
    v_cvt_pk_bf16_f32 v19, v50, v51
    global_store_dwordx4 v2, v[4:7], s[10:11] offset:0 nt
    global_store_dwordx4 v2, v[8:11], s[10:11] offset:256 nt
    global_store_dwordx4 v2, v[12:15], s[10:11] offset:512 nt
    global_store_dwordx4 v2, v[16:19], s[10:11] offset:768 nt
L_done:
s_endpgm
.section .rodata,"a"
.p2align 6
.amdhsa_kernel standalone__instancenorm__sampling_kernel
  .amdhsa_next_free_vgpr 64
  .amdhsa_next_free_sgpr 28
  .amdhsa_accum_offset 64
  .amdhsa_group_segment_fixed_size 0
  .amdhsa_kernarg_size 48
  .amdhsa_user_sgpr_count 2
  .amdhsa_user_sgpr_kernarg_segment_ptr 1
  .amdhsa_system_sgpr_workgroup_id_x 1
  .amdhsa_float_denorm_mode_32 3
.end_amdhsa_kernel
```
